```python
import torch

def _softmax(x, axis=-1):
    return torch.softmax(x, dim=axis)
def _gelu(x):
    return torch.nn.functional.gelu(x, approximate="tanh")
def _silu(x):
    return torch.nn.functional.silu(x)
def _sigmoid(x):
    return torch.sigmoid(x)
def _layernorm(x, axis=-1, eps=1e-5):
    m = x.mean(dim=axis, keepdim=True)
    v = x.var(dim=axis, keepdim=True, unbiased=False)
    return (x - m) / torch.sqrt(v + eps)
def _scatter_add(tgt, idx, src, axis=0):
    return tgt.clone().index_add_(axis, idx, src)
def _segment_sum(src, seg, n):
    out = torch.zeros((n,) + src.shape[1:], dtype=src.dtype)
    return out.index_add_(0, seg, src)
def _pad(x, pw):
    flat = tuple(v for pair in reversed(pw) for v in pair)
    return torch.nn.functional.pad(x, flat)

kernel_name = 'parallel_sum__sliding_block_cached__geglu_ffn__decode'

def setup_inputs():

    _w = (lambda a: (lambda t: t.to(torch.bfloat16) if t.is_floating_point() else t)(torch.as_tensor(a)))
    def _A_setup():
        B, Sq, D = 1, 1, 1024
        Hq, Hkv, Sk, Dh = 32, 4, 65536, 128
        assert Hq % Hkv == 0, (Hq, Hkv)
        return {
            "x": _w((lambda *s: torch.randn(*s, dtype=torch.bfloat16) * 0.05)(B, Sq, D)),
            "k_cache": _w((lambda *s: torch.randn(*s, dtype=torch.bfloat16) * 3.2)(B, Hkv, Sk, Dh)),
            "v_cache": _w((lambda *s: torch.randn(*s, dtype=torch.bfloat16) * 1.6)(B, Hkv, Sk, Dh)),
            "wq": _w((lambda *s: torch.randn(*s, dtype=torch.bfloat16) * 3.2)(D, Hq * Dh) * (D ** -0.5)),
            "wo": _w((lambda *s: torch.randn(*s, dtype=torch.bfloat16) * 1.6)(Hq * Dh, D) * ((Hq * Dh) ** -0.5)),
        }
    _A_in = _A_setup()

    def _B_setup():
        B, S, D, F = 1, 1, 1024, 3584
        return {
            "x": _w((lambda *s: torch.randn(*s, dtype=torch.bfloat16) * 0.05)(B, S, D)),
            "w_gate": _w((lambda *s: torch.randn(*s, dtype=torch.bfloat16) * 0.05)(D, F)),
            "w_up": _w((lambda *s: torch.randn(*s, dtype=torch.bfloat16) * 0.05)(D, F)),
            "w_down": _w((lambda *s: torch.randn(*s, dtype=torch.bfloat16) * 0.05)(F, D)),
        }
    _B_in = _B_setup()

    return {
        "A_x": _A_in["x"],
        "A_k_cache": _A_in["k_cache"],
        "A_v_cache": _A_in["v_cache"],
        "A_wq": _A_in["wq"],
        "A_wo": _A_in["wo"],
        "B_x": _B_in["x"],
        "B_w_gate": _B_in["w_gate"],
        "B_w_up": _B_in["w_up"],
        "B_w_down": _B_in["w_down"],
    }

def reference(A_x, A_k_cache, A_v_cache, A_wq, A_wo, B_x, B_w_gate, B_w_up, B_w_down):
    def _A_ref(x, k_cache, v_cache, wq, wo):
        B, Sq, D = x.shape
        Hq, Dh = 32, 128
        Hkv, Sk = k_cache.shape[1], k_cache.shape[2]
        W = min(4096, max(256, Sk // 4))
        rep = Hq // Hkv
        q = (lambda x, *d: x.permute(*d))((x @ wq).reshape(B, Sq, Hq, Dh), 0, 2, 1, 3)
        k = (lambda x, n, axis: torch.repeat_interleave(x, n, dim=axis))(k_cache[:, :, Sk - W:, :], rep, axis=1)
        v = (lambda x, n, axis: torch.repeat_interleave(x, n, dim=axis))(v_cache[:, :, Sk - W:, :], rep, axis=1)
        scores = torch.einsum("bhqd,bhkd->bhqk", q, k) * (Dh ** -0.5)
        p = _softmax(scores, axis=-1)
        o = torch.einsum("bhqk,bhkd->bhqd", p, v)
        return (lambda x, *d: x.permute(*d))(o, 0, 2, 1, 3).reshape(B, Sq, Hq * Dh) @ wo

    def _B_ref(x, w_gate, w_up, w_down):
        return (_gelu(x @ w_gate) * (x @ w_up)) @ w_down

    x = A_x
    xn = _layernorm(x, axis=-1)
    return x + _A_ref(xn, A_k_cache, A_v_cache, A_wq, A_wo) + _B_ref(xn, B_w_gate, B_w_up, B_w_down)
```

```asm
; @launch grid=(256,1,1) block=(576,1,1) lds=83968
.amdgcn_target "amdgcn-amd-amdhsa--gfx950"
.text
.globl parallel_sum__sliding_block_cached__geglu_ffn__decode_kernel
.p2align 8
.type parallel_sum__sliding_block_cached__geglu_ffn__decode_kernel,@function
parallel_sum__sliding_block_cached__geglu_ffn__decode_kernel:
    s_load_dwordx16 s[4:19], s[0:1], 0
    s_load_dwordx8 s[20:27], s[0:1], 64
    s_getpc_b64 s[74:75]
    v_min_u32 v5, (L_end - parallel_sum__sliding_block_cached__geglu_ffn__decode_kernel) / 128 - 1, v0
    v_lshlrev_b32 v5, 7, v5
    global_load_dword v67, v5, s[74:75]
    v_lshrrev_b32 v4, 6, v0
    v_and_b32 v0, 63, v0
    s_bfe_u32 s58, s2, 0x20001
    v_readfirstlane_b32 s3, v4
    s_lshr_b32 s59, s2, 3
    v_lshrrev_b32 v1, 4, v0
    v_and_b32 v2, 15, v0
    v_lshlrev_b32 v2, 4, v2
    s_lshr_b32 s66, s59, 2
    s_and_b32 s67, s59, 3
    s_lshl2_add_u32 s67, s58, s67
    s_lshl_b32 s67, s67, 1
    s_mul_i32 s69, s58, 7
    s_add_u32 s69, s69, s66
    s_and_b32 s68, s59, 1
    s_lshl_b32 s68, s68, 1
    s_movk_i32 s65, 0x2000
    s_bitcmp0_b32 s2, 0
    s_cselect_b32 s66, s68, s66
    s_cselect_b32 s67, s69, s67
    s_cmovk_i32 s65, 0x1c00
    s_cselect_b32 s68, 28, 32
    s_cselect_b32 s61, 4, 5
    s_cselect_b32 s69, 2, 1
    s_cmp_ge_u32 s59, s68
    s_cbranch_scc1 L_end
    s_cmp_eq_u32 s3, 8
    s_cbranch_scc1 L_roleS
    s_lshl_b32 s66, s66, 6
    s_add_u32 s66, s66, s3
    s_lshl_b32 s66, s66, s69
    v_lshrrev_b32 v4, s61, v0
    v_bfe_u32 v5, v0, 0, s61
    v_lshlrev_b32 v5, 4, v5
    s_mul_i32 s68, s66, s65
    s_lshl_b32 s67, s67, 8
    s_add_u32 s68, s68, s67
    v_mad_u32_u24 v154, v4, s65, v5
    v_add_u32 v154, s68, v154
    s_add_u32 s69, s69, 3
    s_lshl_b32 s30, s65, 10
    s_lshl_b32 s31, 1, 17
    s_lshl_b32 s65, s65, s69
    s_mov_b32 s62, 0
    s_bitcmp0_b32 s59, 1
    s_waitcnt lgkmcnt(0)
    s_cselect_b64 s[28:29], s[16:17], s[18:19]
    s_bitcmp0_b32 s2, 0
    s_cselect_b64 s[28:29], s[28:29], s[10:11]
    buffer_load_dwordx4 v[36:39], v154, s[28:31], s62 offen nt
    s_add_u32 s62, s62, s65
    buffer_load_dwordx4 v[40:43], v154, s[28:31], s62 offen nt
    s_add_u32 s62, s62, s65
    buffer_load_dwordx4 v[44:47], v154, s[28:31], s62 offen nt
    s_add_u32 s62, s62, s65
    s_load_dword s56, s[26:27], 0
    s_mov_b32 s89, 2097024
    s_load_dword s88, s[26:27], s89
    s_bitcmp0_b32 s2, 0
    s_cbranch_scc1 L_roleB
    buffer_load_dwordx4 v[48:51], v154, s[28:31], s62 offen nt
    s_add_u32 s62, s62, s65
    s_branch L_roleA
L_roleS:
    s_setprio 3
    s_mov_b32 s50, 2048
    s_mov_b32 s51, 0x20000
    v_lshlrev_b32 v6, 5, v0
    s_waitcnt lgkmcnt(0)
    s_mov_b64 s[48:49], s[4:5]
    buffer_load_dwordx4 v[100:103], v6, s[48:51], 0 offen
    buffer_load_dwordx4 v[104:107], v6, s[48:51], 0 offen offset:16
    s_branch L_roleS2
L_roleA:
    s_mov_b64 s[48:49], s[4:5]
    s_mov_b32 s50, 2048
    s_mov_b32 s51, 0x20000
    s_lshl_b32 s67, s66, 1
    v_and_b32 v5, 0x70, v2
    v_lshlrev_b32 v5, 1, v5
    v_lshl_add_u32 v4, v4, 1, v5
    v_add_u32 v156, s67, v4
    buffer_load_ushort v108, v156, s[48:51], 0 offen
    s_mov_b64 s[44:45], s[26:27]
    s_mov_b32 s46, 268435456
    s_mov_b32 s47, 0x20000
    v_and_b32 v4, 1, v0
    v_lshlrev_b32 v4, 4, v4
    v_mov_b32 v5, 0xffff
    v_lshlrev_b32 v5, v4, v5
    v_bfe_u32 v6, v0, 1, 2
    v_cmp_eq_u32 s[74:75], 0, v6
    v_cmp_eq_u32 s[76:77], 1, v6
    v_cmp_eq_u32 s[78:79], 2, v6
    v_cmp_eq_u32 vcc, 3, v6
    v_cndmask_b32 v12, 0, v5, s[74:75]
    v_cndmask_b32 v13, 0, v5, s[76:77]
    v_cndmask_b32 v14, 0, v5, s[78:79]
    v_cndmask_b32 v15, 0, v5, vcc
    v_and_b32 v4, 112, v2
    v_lshl_add_u32 v160, v1, 2, v4
    s_lshl_b32 s68, s3, 9
    v_lshlrev_b32 v4, 1, v2
    v_lshl_add_u32 v4, v1, 4, v4
    v_add_u32 v159, s68, v4
    s_mov_b64 s[36:37], s[6:7]
    s_mov_b32 s38, 67108864
    s_mov_b32 s39, 0x20000
    s_mov_b64 s[40:41], s[8:9]
    s_mov_b32 s42, 67108864
    s_mov_b32 s43, 0x20000
    s_mov_b64 s[32:33], s[12:13]
    s_mov_b32 s34, 8388608
    s_mov_b32 s35, 0x20000
    s_lshl_b32 s68, s58, 24
    s_lshl_b32 s69, s59, 15
    s_add_u32 s68, s68, s69
    s_lshl_b32 s61, s3, 12
    s_add_u32 s68, s68, s61
    s_add_u32 s68, s68, 15728640
    v_lshlrev_b32 v6, 8, v1
    v_add_u32 v6, s68, v6
    v_lshlrev_b32 v7, 4, v1
    v_xor_b32 v7, v7, v2
    v_xor_b32 v8, 0, v7
    v_add_u32 v132, v8, v6
    v_xor_b32 v8, 64, v7
    v_add_u32 v133, v8, v6
    v_xor_b32 v8, 128, v7
    v_add_u32 v134, v8, v6
    v_xor_b32 v8, 192, v7
    v_add_u32 v135, v8, v6
    v_lshlrev_b32 v8, 5, v1
    v_xor_b32 v8, v8, v2
    v_add_u32 v136, v8, v6
    v_xor_b32 v8, 128, v8
    v_add_u32 v137, v8, v6
    s_add_u32 m0, s61, 16384
    v_lshl_add_u32 v8, v2, 4, s61
    v_xor_b32 v9, 0, v7
    v_add_u32 v140, v9, v8
    v_xor_b32 v9, 64, v7
    v_add_u32 v141, v9, v8
    v_xor_b32 v9, 128, v7
    v_add_u32 v142, v9, v8
    v_xor_b32 v9, 192, v7
    v_add_u32 v143, v9, v8
    v_bfe_u32 v8, v0, 2, 2
    v_lshl_add_u32 v9, v1, 3, v8
    v_lshlrev_b32 v9, 8, v9
    v_and_b32 v10, 1, v1
    v_lshl_or_b32 v8, v10, 2, v8
    v_xor_b32 v8, s3, v8
    v_lshlrev_b32 v8, 5, v8
    v_and_b32 v10, 3, v0
    v_lshlrev_b32 v10, 3, v10
    v_add3_u32 v161, v8, v9, v10
    v_add_u32 v161, 49152, v161
    v_and_b32 v8, 7, v0
    v_lshlrev_b32 v165, 2, v8
    v_mul_u32_u24 v8, 288, v8
    v_lshl_add_u32 v162, v1, 4, v8
    s_lshl_b32 s68, s3, 5
    v_lshl_add_u32 v163, v1, 3, v8
    v_add_u32 v163, s68, v163
    s_lshl_b32 s68, s58, 15
    s_lshl_b32 s69, s3, 12
    s_add_u32 s68, s68, s69
    s_add_u32 s68, s68, 65536
    v_lshl_add_u32 v158, v0, 4, s68
    s_mul_i32 s68, s3, 288
    v_and_b32 v8, 31, v0
    v_lshlrev_b32 v8, 3, v8
    v_lshrrev_b32 v9, 5, v0
    v_lshl_add_u32 v8, v9, 2, v8
    v_add_u32 v167, s68, v8
    s_mov_b32 s86, 0x0c0c0400
    s_mov_b32 s87, 0x04000c0c
    s_lshl_b32 s68, s58, 17
    s_lshr_b32 s69, s3, 1
    s_lshl_b32 s69, s69, 12
    s_add_u32 s68, s68, s69
    s_lshl_b32 s69, s59, 7
    s_add_u32 s68, s68, s69
    s_and_b32 s69, s3, 1
    s_lshl_b32 s69, s69, 6
    s_add_u32 s68, s68, s69
    s_add_u32 s68, s68, 262144
    v_lshlrev_b32 v8, 12, v165
    v_lshlrev_b32 v9, 4, v1
    v_add3_u32 v164, v8, v9, s68
    s_lshl_b32 s60, s58, 5
    s_add_u32 s60, s60, s59
    s_lshl_b32 s66, s60, 5
    s_lshl_b32 s68, s66, 11
    s_lshl_b32 s69, s3, 8
    s_add_u32 s68, s68, s69
    v_lshlrev_b32 v4, 11, v1
    v_add3_u32 v155, v4, v2, s68
    s_mov_b32 s63, 0
    v_bfe_u32 v4, v0, 2, 2
    v_lshlrev_b32 v4, 15, v4
    v_and_b32 v5, 3, v0
    v_lshlrev_b32 v5, 5, v5
    v_and_b32 v6, 16, v0
    v_add3_u32 v4, v4, v5, v6
    s_lshl_b32 s68, s3, 17
    s_lshl_b32 s69, s60, 7
    s_add_u32 s68, s68, s69
    s_add_u32 s68, s68, 1048576
    v_add_u32 v157, s68, v4
    s_lshl_b32 s68, s3, 9
    v_lshlrev_b32 v4, 2, v165
    v_lshl_add_u32 v4, v1, 7, v4
    v_add_u32 v166, s68, v4
    v_lshrrev_b32 v4, 3, v0
    v_xor_b32 v4, v4, v1
    v_and_b32 v4, 1, v4
    v_add_u32 v4, -1, v4
    v_and_b32 v32, v4, v12
    v_and_b32 v33, v4, v13
    v_and_b32 v34, v4, v14
    v_and_b32 v35, v4, v15
    s_lshl_b32 s68, s3, 10
    v_lshrrev_b32 v4, 5, v0
    v_lshlrev_b32 v4, 9, v4
    v_lshl_add_u32 v4, v2, 1, v4
    v_and_b32 v5, 16, v0
    v_add3_u32 v159, v4, v5, s68
    v_mov_b32 v4, 0xff800000
    ds_write_b32 v165, v4 offset:13312
    s_waitcnt lgkmcnt(0)
    s_add_u32 s56, s56, 1
    s_mul_i32 s57, s88, 0x9e3779b2
    s_add_u32 s57, s57, s56
    s_mul_i32 s57, s57, 0x01010101
    s_add_u32 s88, s88, 1
    v_mov_b32 v16, s57
    v_lshrrev_b32 v17, 8, v16
    v_lshrrev_b32 v18, 16, v16
    v_lshrrev_b32 v19, 24, v16
    s_mov_b32 s73, 0xffffff00
    s_mov_b32 s72, 2000000
    s_mov_b32 s64, 4194304
    s_getreg_b32 s84, hwreg(HW_REG_XCC_ID, 0, 4)
    s_add_u32 s84, s84, 1
    s_lshl_b32 s84, s84, 27
    s_xor_b32 s82, s57, s84
    s_mov_b32 s70, 0
    s_mov_b32 s71, 0
    s_mov_b32 s83, s82
    s_barrier
    s_waitcnt vmcnt(4)
    buffer_load_dwordx4 v[52:55], v154, s[28:31], s62 offen nt
    s_add_u32 s62, s62, s65
    s_waitcnt vmcnt(4)
    buffer_load_dwordx4 v[56:59], v154, s[28:31], s62 offen nt
    s_add_u32 s62, s62, s65
    s_waitcnt vmcnt(4)
    buffer_load_dwordx4 v[60:63], v154, s[28:31], s62 offen nt
    s_add_u32 s62, s62, s65
    s_waitcnt vmcnt(4)
    buffer_load_dwordx4 v[64:67], v154, s[28:31], s62 offen nt
    s_add_u32 s62, s62, s65
    s_waitcnt vmcnt(4)
    v_mov_b32 v7, 0
    v_lshlrev_b32 v116, 16, v108
LA_ln:
    ds_read_b128 v[8:11], v7 offset:14080
    s_waitcnt lgkmcnt(0)
    v_cmp_eq_u32 vcc, 0, v11
    s_cbranch_vccnz LA_ln
    v_sub_f32 v116, v116, v8
    v_cvt_pk_bf16_f32 v116, v116, v116
    v_and_b32 v116, 0xffff0000, v116
    v_mul_f32 v4, v116, v10
    v_fma_f32 v5, -v4, v9, v116
    v_fma_f32 v4, v5, v10, v4
    v_cvt_pk_bf16_f32 v3, v4, v4
    s_nop 1
    v_and_b32_dpp v20, v3, v32 row_newbcast:0 row_mask:0xf bank_mask:0xf
    v_and_b32_dpp v21, v3, v33 row_newbcast:0 row_mask:0xf bank_mask:0xf
    v_and_b32_dpp v22, v3, v34 row_newbcast:0 row_mask:0xf bank_mask:0xf
    v_and_b32_dpp v23, v3, v35 row_newbcast:0 row_mask:0xf bank_mask:0xf
    v_and_b32_dpp v24, v3, v32 row_newbcast:1 row_mask:0xf bank_mask:0xf
    v_and_b32_dpp v25, v3, v33 row_newbcast:1 row_mask:0xf bank_mask:0xf
    v_and_b32_dpp v26, v3, v34 row_newbcast:1 row_mask:0xf bank_mask:0xf
    v_and_b32_dpp v27, v3, v35 row_newbcast:1 row_mask:0xf bank_mask:0xf
    s_waitcnt vmcnt(8)
    v_mfma_f32_16x16x32_bf16 v[28:31], v[20:23], v[36:39], 0
    v_and_b32_dpp v20, v3, v32 row_newbcast:2 row_mask:0xf bank_mask:0xf
    v_and_b32_dpp v21, v3, v33 row_newbcast:2 row_mask:0xf bank_mask:0xf
    v_and_b32_dpp v22, v3, v34 row_newbcast:2 row_mask:0xf bank_mask:0xf
    v_and_b32_dpp v23, v3, v35 row_newbcast:2 row_mask:0xf bank_mask:0xf
    s_waitcnt vmcnt(7)
    v_mfma_f32_16x16x32_bf16 v[28:31], v[24:27], v[40:43], v[28:31]
    v_and_b32_dpp v24, v3, v32 row_newbcast:3 row_mask:0xf bank_mask:0xf
    v_and_b32_dpp v25, v3, v33 row_newbcast:3 row_mask:0xf bank_mask:0xf
    v_and_b32_dpp v26, v3, v34 row_newbcast:3 row_mask:0xf bank_mask:0xf
    v_and_b32_dpp v27, v3, v35 row_newbcast:3 row_mask:0xf bank_mask:0xf
    s_waitcnt vmcnt(6)
    v_mfma_f32_16x16x32_bf16 v[28:31], v[20:23], v[44:47], v[28:31]
    v_and_b32_dpp v20, v3, v32 row_newbcast:4 row_mask:0xf bank_mask:0xf
    v_and_b32_dpp v21, v3, v33 row_newbcast:4 row_mask:0xf bank_mask:0xf
    v_and_b32_dpp v22, v3, v34 row_newbcast:4 row_mask:0xf bank_mask:0xf
    v_and_b32_dpp v23, v3, v35 row_newbcast:4 row_mask:0xf bank_mask:0xf
    s_waitcnt vmcnt(5)
    v_mfma_f32_16x16x32_bf16 v[28:31], v[24:27], v[48:51], v[28:31]
    v_and_b32_dpp v24, v3, v32 row_newbcast:5 row_mask:0xf bank_mask:0xf
    v_and_b32_dpp v25, v3, v33 row_newbcast:5 row_mask:0xf bank_mask:0xf
    v_and_b32_dpp v26, v3, v34 row_newbcast:5 row_mask:0xf bank_mask:0xf
    v_and_b32_dpp v27, v3, v35 row_newbcast:5 row_mask:0xf bank_mask:0xf
    s_waitcnt vmcnt(3)
    v_mfma_f32_16x16x32_bf16 v[28:31], v[20:23], v[52:55], v[28:31]
    buffer_load_dwordx4 v132, s[36:39], 0 offen offset:0 nt lds
    v_and_b32_dpp v20, v3, v32 row_newbcast:6 row_mask:0xf bank_mask:0xf
    v_and_b32_dpp v21, v3, v33 row_newbcast:6 row_mask:0xf bank_mask:0xf
    v_and_b32_dpp v22, v3, v34 row_newbcast:6 row_mask:0xf bank_mask:0xf
    v_and_b32_dpp v23, v3, v35 row_newbcast:6 row_mask:0xf bank_mask:0xf
    s_waitcnt vmcnt(3)
    v_mfma_f32_16x16x32_bf16 v[28:31], v[24:27], v[56:59], v[28:31]
    v_and_b32_dpp v24, v3, v32 row_newbcast:7 row_mask:0xf bank_mask:0xf
    v_and_b32_dpp v25, v3, v33 row_newbcast:7 row_mask:0xf bank_mask:0xf
    v_and_b32_dpp v26, v3, v34 row_newbcast:7 row_mask:0xf bank_mask:0xf
    v_and_b32_dpp v27, v3, v35 row_newbcast:7 row_mask:0xf bank_mask:0xf
    s_waitcnt vmcnt(2)
    v_mfma_f32_16x16x32_bf16 v[28:31], v[20:23], v[60:63], v[28:31]
    s_waitcnt vmcnt(1)
    v_mfma_f32_16x16x32_bf16 v[28:31], v[24:27], v[64:67], v[28:31]
    s_nop 7
    ds_write_b128 v159, v[28:31] offset:0
    s_waitcnt lgkmcnt(0)
    s_barrier
    v_mov_b32 v32, 0x3f803f80
    v_mov_b32 v33, 0x3f803f80
    v_mov_b32 v34, 0x3f803f80
    v_mov_b32 v35, 0x3f803f80
    s_barrier
    buffer_load_dwordx4 v133, s[36:39], 0 offen offset:1024 nt lds
    buffer_load_dwordx4 v134, s[36:39], 0 offen offset:2048 nt lds
    buffer_load_dwordx4 v135, s[36:39], 0 offen offset:3072 nt lds
    s_waitcnt vmcnt(1)
    buffer_load_dwordx4 v[100:103], v158, s[44:47], s70 offen offset:0 sc1
    buffer_load_dwordx4 v[104:107], v158, s[44:47], s70 offen offset:1024 sc1
    buffer_load_dwordx4 v[108:111], v158, s[44:47], s70 offen offset:2048 sc1
    buffer_load_dwordx4 v[112:115], v158, s[44:47], s70 offen offset:3072 sc1
    s_barrier
    s_add_u32 m0, s61, 49152
    s_nop 0
    buffer_load_dwordx4 v136, s[40:43], 0 offen offset:0 nt lds
    buffer_load_dwordx4 v136, s[40:43], 0 offen offset:1024 nt lds
    buffer_load_dwordx4 v137, s[40:43], 0 offen offset:2048 nt lds
    buffer_load_dwordx4 v137, s[40:43], 0 offen offset:3072 nt lds
    s_waitcnt vmcnt(4)
    ds_read_b128 v[36:39], v140 offset:16384
    ds_read_b128 v[40:43], v141 offset:16384
    ds_read_b128 v[44:47], v142 offset:16384
    ds_read_b128 v[48:51], v143 offset:16384
    v_perm_b32 v4, v101, v100, s86
    v_perm_b32 v5, v103, v102, s87
    v_perm_b32 v6, v105, v104, s86
    v_perm_b32 v7, v107, v106, s87
    v_perm_b32 v8, v109, v108, s86
    v_perm_b32 v9, v111, v110, s87
    v_perm_b32 v10, v113, v112, s86
    v_perm_b32 v11, v115, v114, s87
    v_bitop3_b32 v4, v4, v5, s83 bitop3:0x56
    v_bitop3_b32 v6, v6, v7, s83 bitop3:0x56
    v_bitop3_b32 v8, v8, v9, s83 bitop3:0x56
    v_bitop3_b32 v10, v10, v11, s83 bitop3:0x56
    v_or3_b32 v4, v4, v6, v8
    v_or_b32 v4, v4, v10
    v_cmp_ne_u32 vcc, 0, v4
    s_cbranch_vccz LA_qok
LA_qpoll:
    buffer_load_dwordx4 v[100:103], v158, s[44:47], s70 offen offset:0 sc1
    buffer_load_dwordx4 v[104:107], v158, s[44:47], s70 offen offset:1024 sc1
    buffer_load_dwordx4 v[108:111], v158, s[44:47], s70 offen offset:2048 sc1
    buffer_load_dwordx4 v[112:115], v158, s[44:47], s70 offen offset:3072 sc1
    s_waitcnt vmcnt(0)
    v_perm_b32 v4, v101, v100, s86
    v_perm_b32 v5, v103, v102, s87
    v_perm_b32 v6, v105, v104, s86
    v_perm_b32 v7, v107, v106, s87
    v_perm_b32 v8, v109, v108, s86
    v_perm_b32 v9, v111, v110, s87
    v_perm_b32 v10, v113, v112, s86
    v_perm_b32 v11, v115, v114, s87
    v_bitop3_b32 v4, v4, v5, s83 bitop3:0x56
    v_bitop3_b32 v6, v6, v7, s83 bitop3:0x56
    v_bitop3_b32 v8, v8, v9, s83 bitop3:0x56
    v_bitop3_b32 v10, v10, v11, s83 bitop3:0x56
    v_or3_b32 v4, v4, v6, v8
    v_or_b32 v4, v4, v10
    v_cmp_ne_u32 vcc, 0, v4
    s_cbranch_vccz LA_qok
    s_add_u32 s71, s71, 1
    s_cmp_lt_u32 s71, 32
    s_cbranch_scc1 LA_qpoll
    s_cmp_lg_u32 s71, 32
    s_cbranch_scc1 LA_qpoll_sw
    v_lshlrev_b32 v8, 4, v0
    ds_read_b128 v[68:71], v8 offset:0
    ds_read_b128 v[72:75], v8 offset:1024
    ds_read_b128 v[76:79], v8 offset:2048
    ds_read_b128 v[80:83], v8 offset:3072
    ds_read_b128 v[84:87], v8 offset:4096
    ds_read_b128 v[88:91], v8 offset:5120
    ds_read_b128 v[92:95], v8 offset:6144
    ds_read_b128 v[96:99], v8 offset:7168
    s_waitcnt lgkmcnt(6)
    v_pk_add_f32 v[68:69], v[68:69], v[72:73]
    v_pk_add_f32 v[70:71], v[70:71], v[74:75]
    s_waitcnt lgkmcnt(4)
    v_pk_add_f32 v[76:77], v[76:77], v[80:81]
    v_pk_add_f32 v[78:79], v[78:79], v[82:83]
    s_waitcnt lgkmcnt(2)
    v_pk_add_f32 v[84:85], v[84:85], v[88:89]
    v_pk_add_f32 v[86:87], v[86:87], v[90:91]
    s_waitcnt lgkmcnt(0)
    v_pk_add_f32 v[92:93], v[92:93], v[96:97]
    v_pk_add_f32 v[94:95], v[94:95], v[98:99]
    v_pk_add_f32 v[68:69], v[68:69], v[76:77]
    v_pk_add_f32 v[70:71], v[70:71], v[78:79]
    v_pk_add_f32 v[84:85], v[84:85], v[92:93]
    v_pk_add_f32 v[86:87], v[86:87], v[94:95]
    v_pk_add_f32 v[68:69], v[68:69], v[84:85]
    v_pk_add_f32 v[70:71], v[70:71], v[86:87]
    v_add_u32 v68, 0x80, v68
    v_add_u32 v69, 0x80, v69
    v_add_u32 v70, 0x80, v70
    v_add_u32 v71, 0x80, v71
    v_bfi_b32 v4, s73, v68, v16
    v_bfi_b32 v5, s73, v69, v17
    v_bfi_b32 v6, s73, v70, v18
    v_bfi_b32 v7, s73, v71, v19
    s_lshl_b32 s66, s58, 15
    s_and_b32 s67, s59, 3
    s_lshl_b32 s67, s67, 13
    s_add_u32 s66, s66, s67
    s_lshr_b32 s67, s59, 2
    s_lshl_b32 s67, s67, 9
    s_add_u32 s66, s66, s67
    s_add_u32 s66, s66, 65536
    v_and_b32 v9, 31, v0
    v_lshlrev_b32 v9, 4, v9
    v_lshrrev_b32 v10, 5, v0
    v_lshlrev_b32 v10, 12, v10
    v_add3_u32 v8, v9, v10, s66
    buffer_store_dwordx4 v[4:7], v8, s[44:47], s64 offen sc1
LA_qpoll_sw:
    s_xor_b32 s70, s70, s64
    s_xor_b32 s83, s83, s84
    s_sub_u32 s72, s72, 1
    s_cbranch_scc0 LA_qpoll
    s_mov_b32 s72, 0
LA_qok:
    v_and_b32 v100, s73, v100
    v_and_b32 v101, s73, v101
    v_and_b32 v102, s73, v102
    v_and_b32 v103, s73, v103
    v_and_b32 v104, s73, v104
    v_and_b32 v105, s73, v105
    v_and_b32 v106, s73, v106
    v_and_b32 v107, s73, v107
    v_and_b32 v108, s73, v108
    v_and_b32 v109, s73, v109
    v_and_b32 v110, s73, v110
    v_and_b32 v111, s73, v111
    v_and_b32 v112, s73, v112
    v_and_b32 v113, s73, v113
    v_and_b32 v114, s73, v114
    v_and_b32 v115, s73, v115
    v_pk_add_f32 v[100:101], v[100:101], v[104:105]
    v_pk_add_f32 v[102:103], v[102:103], v[106:107]
    v_pk_add_f32 v[108:109], v[108:109], v[112:113]
    v_pk_add_f32 v[110:111], v[110:111], v[114:115]
    v_pk_add_f32 v[100:101], v[100:101], v[108:109]
    v_pk_add_f32 v[102:103], v[102:103], v[110:111]
    s_nop 1
    v_permlane32_swap_b32 v100, v102
    v_permlane32_swap_b32 v101, v103
    v_pk_add_f32 v[100:101], v[100:101], v[102:103]
    v_cvt_pk_bf16_f32 v100, v100, v101
    ds_write_b32 v167, v100 offset:8192
    buffer_load_dwordx4 v[68:71], v155, s[32:35], s63 offen nt
    s_add_u32 s63, s63, 8192
    s_waitcnt lgkmcnt(0)
    s_barrier
    ds_read_b128 v[52:55], v162 offset:8192
    ds_read_b128 v[56:59], v162 offset:8256
    ds_read_b128 v[60:63], v162 offset:8320
    ds_read_b128 v[64:67], v162 offset:8384
    s_waitcnt lgkmcnt(3)
    v_mfma_f32_16x16x32_bf16 v[28:31], v[36:39], v[52:55], 0
    s_waitcnt lgkmcnt(2)
    v_mfma_f32_16x16x32_bf16 v[28:31], v[40:43], v[56:59], v[28:31]
    s_waitcnt lgkmcnt(1)
    v_mfma_f32_16x16x32_bf16 v[28:31], v[44:47], v[60:63], v[28:31]
    s_waitcnt lgkmcnt(0)
    v_mfma_f32_16x16x32_bf16 v[28:31], v[48:51], v[64:67], v[28:31]
    s_mov_b32 s68, 0x3db504f3
    s_nop 6
    v_cvt_pk_bf16_f32 v4, v28, v29
    v_cvt_pk_bf16_f32 v5, v30, v31
    v_lshlrev_b32 v116, 16, v4
    v_and_b32 v117, 0xffff0000, v4
    v_lshlrev_b32 v118, 16, v5
    v_and_b32 v119, 0xffff0000, v5
    v_pk_mul_f32 v[116:117], v[116:117], s[68:69] op_sel_hi:[1,0]
    v_pk_mul_f32 v[118:119], v[118:119], s[68:69] op_sel_hi:[1,0]
    v_cvt_pk_bf16_f32 v4, v116, v117
    v_cvt_pk_bf16_f32 v5, v118, v119
    v_lshlrev_b32 v116, 16, v4
    v_and_b32 v117, 0xffff0000, v4
    v_lshlrev_b32 v118, 16, v5
    v_and_b32 v119, 0xffff0000, v5
    v_max3_f32 v4, v116, v117, v118
    v_max_f32 v4, v4, v119
    ds_max_f32 v165, v4 offset:13312
    buffer_load_dwordx4 v[72:75], v155, s[32:35], s63 offen nt
    s_add_u32 s63, s63, 8192
    s_waitcnt lgkmcnt(0)
    s_barrier
    ds_read_b32 v148, v165 offset:13312
    s_mov_b32 s68, 0x3fb8aa3b
    s_waitcnt lgkmcnt(0)
    v_pk_add_f32 v[116:117], v[116:117], v[148:149] op_sel_hi:[1,0] neg_lo:[0,1] neg_hi:[0,1]
    v_pk_add_f32 v[118:119], v[118:119], v[148:149] op_sel_hi:[1,0] neg_lo:[0,1] neg_hi:[0,1]
    v_pk_mul_f32 v[116:117], v[116:117], s[68:69] op_sel_hi:[1,0]
    v_pk_mul_f32 v[118:119], v[118:119], s[68:69] op_sel_hi:[1,0]
    v_exp_f32 v116, v116
    v_exp_f32 v117, v117
    v_exp_f32 v118, v118
    v_exp_f32 v119, v119
    v_cvt_pk_bf16_f32 v4, v116, v117
    v_cvt_pk_bf16_f32 v5, v118, v119
    ds_write_b64 v163, v[4:5] offset:10752
    v_mul_f32 v148, s68, v148
    s_waitcnt lgkmcnt(0)
    s_barrier
    ds_read_b128 v[52:55], v162 offset:10752
    ds_read_b128 v[56:59], v162 offset:10816
    ds_read_b128 v[60:63], v162 offset:10880
    ds_read_b128 v[64:67], v162 offset:10944
    s_waitcnt lgkmcnt(3)
    v_mfma_f32_16x16x32_bf16 v[24:27], v[32:35], v[52:55], 0
    s_waitcnt lgkmcnt(2)
    v_mfma_f32_16x16x32_bf16 v[24:27], v[32:35], v[56:59], v[24:27]
    s_waitcnt lgkmcnt(1)
    v_mfma_f32_16x16x32_bf16 v[24:27], v[32:35], v[60:63], v[24:27]
    s_waitcnt lgkmcnt(0)
    v_mfma_f32_16x16x32_bf16 v[24:27], v[32:35], v[64:67], v[24:27]
    s_waitcnt vmcnt(2)
    s_barrier
    ds_read_b64_tr_b16 v[100:101], v161 offset:0
    ds_read_b64_tr_b16 v[102:103], v161 offset:1024
    ds_read_b64_tr_b16 v[104:105], v161 offset:8192
    ds_read_b64_tr_b16 v[106:107], v161 offset:9216
    ds_read_b64_tr_b16 v[108:109], v161 offset:16384
    ds_read_b64_tr_b16 v[110:111], v161 offset:17408
    ds_read_b64_tr_b16 v[112:113], v161 offset:24576
    ds_read_b64_tr_b16 v[114:115], v161 offset:25600
    v_rcp_f32 v152, v24
    v_log_f32 v146, v24
    v_mov_b32 v147, s82
    v_add_f32 v146, v146, v148
    s_waitcnt lgkmcnt(6)
    v_mfma_f32_16x16x32_bf16 v[28:31], v[100:103], v[52:55], 0
    s_waitcnt lgkmcnt(4)
    v_mfma_f32_16x16x32_bf16 v[28:31], v[104:107], v[56:59], v[28:31]
    s_waitcnt lgkmcnt(2)
    v_mfma_f32_16x16x32_bf16 v[28:31], v[108:111], v[60:63], v[28:31]
    s_waitcnt lgkmcnt(0)
    v_mfma_f32_16x16x32_bf16 v[28:31], v[112:115], v[64:67], v[28:31]
    s_mov_b32 exec_lo, 0x00ff00ff
    s_mov_b32 exec_hi, 0x00ff00ff
    s_nop 5
    v_pk_mul_f32 v[28:29], v[28:29], v[152:153] op_sel_hi:[1,0]
    v_pk_mul_f32 v[30:31], v[30:31], v[152:153] op_sel_hi:[1,0]
    v_cvt_pk_bf16_f32 v144, v28, v29
    v_cvt_pk_bf16_f32 v145, v30, v31
    ds_write_b128 v166, v[144:147] offset:0
    buffer_store_dwordx4 v[144:147], v164, s[44:47], 0 offen
    s_mov_b64 exec, -1
    s_waitcnt lgkmcnt(0)
    s_barrier
    buffer_load_dwordx4 v[76:79], v155, s[32:35], s63 offen nt
    s_add_u32 s63, s63, 8192
    buffer_load_dwordx4 v[80:83], v155, s[32:35], s63 offen nt
    s_add_u32 s63, s63, 8192
    buffer_load_dwordx4 v[84:87], v155, s[32:35], s63 offen nt
    s_add_u32 s63, s63, 8192
    s_waitcnt vmcnt(2)
    buffer_load_dwordx4 v[88:91], v155, s[32:35], s63 offen nt
    s_add_u32 s63, s63, 8192
    s_waitcnt vmcnt(2)
    buffer_load_dwordx4 v[92:95], v155, s[32:35], s63 offen nt
    s_add_u32 s63, s63, 8192
    s_waitcnt vmcnt(2)
    buffer_load_dwordx4 v[96:99], v155, s[32:35], s63 offen nt
    s_add_u32 s63, s63, 8192
    v_bfe_u32 v4, v0, 2, 1
    v_add_u32 v5, -1, v4
    v_sub_u32 v4, 0, v4
    v_and_b32 v12, 0xffff, v5
    v_and_b32 v13, 0xffff, v4
    v_and_b32 v14, 0xffff0000, v5
    v_and_b32 v15, 0xffff0000, v4
    v_and_b32 v4, 3, v0
    v_xor_b32 v5, 1, v4
    v_lshl_or_b32 v6, v5, 2, v4
    v_lshl_or_b32 v7, v4, 2, v5
    v_lshl_or_b32 v6, v7, 8, v6
    v_lshl_or_b32 v150, v6, 4, v6
    v_lshlrev_b32 v4, 4, v4
    v_lshl_add_u32 v160, v1, 2, v4
    v_mov_b32 v28, 0
    v_mov_b32 v29, 0
    v_mov_b32 v30, 0
    v_mov_b32 v31, 0
    s_barrier
    ds_read_b32 v3, v160 offset:13376
    s_waitcnt lgkmcnt(0)
    v_and_b32_dpp v20, v3, v12 row_newbcast:0 row_mask:0xf bank_mask:0xf
    v_and_b32_dpp v21, v3, v13 row_newbcast:0 row_mask:0xf bank_mask:0xf
    v_and_b32_dpp v22, v3, v14 row_newbcast:0 row_mask:0xf bank_mask:0xf
    v_and_b32_dpp v23, v3, v15 row_newbcast:0 row_mask:0xf bank_mask:0xf
    v_and_b32_dpp v24, v3, v12 row_newbcast:1 row_mask:0xf bank_mask:0xf
    v_and_b32_dpp v25, v3, v13 row_newbcast:1 row_mask:0xf bank_mask:0xf
    v_and_b32_dpp v26, v3, v14 row_newbcast:1 row_mask:0xf bank_mask:0xf
    v_and_b32_dpp v27, v3, v15 row_newbcast:1 row_mask:0xf bank_mask:0xf
    s_waitcnt vmcnt(6)
    v_smfmac_f32_16x16x64_bf16 v[28:31], v[20:23], v[68:75], v150
    v_and_b32_dpp v20, v3, v12 row_newbcast:2 row_mask:0xf bank_mask:0xf
    v_and_b32_dpp v21, v3, v13 row_newbcast:2 row_mask:0xf bank_mask:0xf
    v_and_b32_dpp v22, v3, v14 row_newbcast:2 row_mask:0xf bank_mask:0xf
    v_and_b32_dpp v23, v3, v15 row_newbcast:2 row_mask:0xf bank_mask:0xf
    s_waitcnt vmcnt(4)
    v_smfmac_f32_16x16x64_bf16 v[28:31], v[24:27], v[76:83], v150
    v_and_b32_dpp v24, v3, v12 row_newbcast:3 row_mask:0xf bank_mask:0xf
    v_and_b32_dpp v25, v3, v13 row_newbcast:3 row_mask:0xf bank_mask:0xf
    v_and_b32_dpp v26, v3, v14 row_newbcast:3 row_mask:0xf bank_mask:0xf
    v_and_b32_dpp v27, v3, v15 row_newbcast:3 row_mask:0xf bank_mask:0xf
    s_waitcnt vmcnt(2)
    v_smfmac_f32_16x16x64_bf16 v[28:31], v[20:23], v[84:91], v150
    s_waitcnt vmcnt(0)
    v_smfmac_f32_16x16x64_bf16 v[28:31], v[24:27], v[92:99], v150
    s_mov_b32 exec_hi, 0
    s_nop 6
    v_bfi_b32 v4, s73, v28, v16
    v_bfi_b32 v5, s73, v29, v17
    v_bfi_b32 v6, s73, v30, v18
    v_bfi_b32 v7, s73, v31, v19
    buffer_store_dwordx4 v[4:7], v157, s[44:47], 0 offen sc1
    s_mov_b32 exec_hi, -1
    s_endpgm
L_roleS2:
    v_mov_b32 v7, 0
    ds_write_b32 v7, v7 offset:14092
    ds_write_b32 v7, v7 offset:14096
    s_waitcnt lgkmcnt(0)
    s_barrier
    s_load_dword s56, s[26:27], 0
    s_mov_b32 s89, 2097024
    s_load_dword s88, s[26:27], s89
    s_mov_b64 s[44:45], s[26:27]
    s_mov_b32 s46, 268435456
    s_mov_b32 s47, 0x20000
    s_bitcmp0_b32 s2, 0
    s_cbranch_scc1 L_roleSB
    s_lshl_b32 s66, s58, 15
    s_and_b32 s67, s59, 3
    s_lshl_b32 s67, s67, 13
    s_add_u32 s66, s66, s67
    s_lshr_b32 s67, s59, 2
    s_lshl_b32 s67, s67, 9
    s_add_u32 s66, s66, s67
    s_add_u32 s66, s66, 65536
    v_and_b32 v9, 31, v0
    v_lshlrev_b32 v9, 4, v9
    v_lshrrev_b32 v10, 5, v0
    v_lshlrev_b32 v10, 12, v10
    v_add3_u32 v161, v9, v10, s66
    s_lshl_b32 s66, s58, 17
    s_lshl_b32 s67, s59, 12
    s_add_u32 s66, s66, s67
    s_add_u32 s66, s66, 262144
    v_lshl_add_u32 v162, v0, 4, s66
    s_waitcnt vmcnt(0)
    v_lshlrev_b32 v116, 16, v100
    v_and_b32 v117, 0xffff0000, v100
    v_lshlrev_b32 v118, 16, v101
    v_and_b32 v119, 0xffff0000, v101
    v_lshlrev_b32 v120, 16, v102
    v_and_b32 v121, 0xffff0000, v102
    v_lshlrev_b32 v122, 16, v103
    v_and_b32 v123, 0xffff0000, v103
    v_lshlrev_b32 v124, 16, v104
    v_and_b32 v125, 0xffff0000, v104
    v_lshlrev_b32 v126, 16, v105
    v_and_b32 v127, 0xffff0000, v105
    v_lshlrev_b32 v128, 16, v106
    v_and_b32 v129, 0xffff0000, v106
    v_lshlrev_b32 v130, 16, v107
    v_and_b32 v131, 0xffff0000, v107
    v_pk_add_f32 v[4:5], v[116:117], v[118:119]
    v_pk_add_f32 v[6:7], v[120:121], v[122:123]
    v_pk_add_f32 v[8:9], v[124:125], v[126:127]
    v_pk_add_f32 v[10:11], v[128:129], v[130:131]
    v_pk_add_f32 v[4:5], v[4:5], v[6:7]
    v_pk_add_f32 v[8:9], v[8:9], v[10:11]
    v_pk_add_f32 v[4:5], v[4:5], v[8:9]
    v_add_f32 v4, v4, v5
    s_nop 1
    v_add_f32_dpp v4, v4, v4 row_shr:1 row_mask:0xf bank_mask:0xf bound_ctrl:0
    s_nop 1
    v_add_f32_dpp v4, v4, v4 row_shr:2 row_mask:0xf bank_mask:0xf bound_ctrl:0
    s_nop 1
    v_add_f32_dpp v4, v4, v4 row_shr:4 row_mask:0xf bank_mask:0xf bound_ctrl:0
    s_nop 1
    v_add_f32_dpp v4, v4, v4 row_shr:8 row_mask:0xf bank_mask:0xf bound_ctrl:0
    s_nop 1
    v_add_f32_dpp v4, v4, v4 row_bcast:15 row_mask:0xa bank_mask:0xf
    s_nop 1
    v_add_f32_dpp v4, v4, v4 row_bcast:31 row_mask:0xc bank_mask:0xf
    v_mul_f32 v4, 0x3a800000, v4
    s_nop 0
    v_readlane_b32 s68, v4, 63
    s_nop 1
    v_pk_add_f32 v[116:117], v[116:117], s[68:69] op_sel_hi:[1,0] neg_lo:[0,1] neg_hi:[0,1]
    v_pk_add_f32 v[118:119], v[118:119], s[68:69] op_sel_hi:[1,0] neg_lo:[0,1] neg_hi:[0,1]
    v_pk_add_f32 v[120:121], v[120:121], s[68:69] op_sel_hi:[1,0] neg_lo:[0,1] neg_hi:[0,1]
    v_pk_add_f32 v[122:123], v[122:123], s[68:69] op_sel_hi:[1,0] neg_lo:[0,1] neg_hi:[0,1]
    v_pk_add_f32 v[124:125], v[124:125], s[68:69] op_sel_hi:[1,0] neg_lo:[0,1] neg_hi:[0,1]
    v_pk_add_f32 v[126:127], v[126:127], s[68:69] op_sel_hi:[1,0] neg_lo:[0,1] neg_hi:[0,1]
    v_pk_add_f32 v[128:129], v[128:129], s[68:69] op_sel_hi:[1,0] neg_lo:[0,1] neg_hi:[0,1]
    v_pk_add_f32 v[130:131], v[130:131], s[68:69] op_sel_hi:[1,0] neg_lo:[0,1] neg_hi:[0,1]
    v_pk_mul_f32 v[4:5], v[116:117], v[116:117]
    v_pk_mul_f32 v[6:7], v[118:119], v[118:119]
    v_pk_fma_f32 v[4:5], v[120:121], v[120:121], v[4:5]
    v_pk_fma_f32 v[6:7], v[122:123], v[122:123], v[6:7]
    v_pk_fma_f32 v[4:5], v[124:125], v[124:125], v[4:5]
    v_pk_fma_f32 v[6:7], v[126:127], v[126:127], v[6:7]
    v_pk_fma_f32 v[4:5], v[128:129], v[128:129], v[4:5]
    v_pk_fma_f32 v[6:7], v[130:131], v[130:131], v[6:7]
    v_pk_add_f32 v[4:5], v[4:5], v[6:7]
    v_add_f32 v4, v4, v5
    v_cvt_pk_bf16_f32 v148, s68, s68
    v_and_b32 v148, 0xffff0000, v148
    v_add_f32_dpp v4, v4, v4 row_shr:1 row_mask:0xf bank_mask:0xf bound_ctrl:0
    s_nop 1
    v_add_f32_dpp v4, v4, v4 row_shr:2 row_mask:0xf bank_mask:0xf bound_ctrl:0
    s_nop 1
    v_add_f32_dpp v4, v4, v4 row_shr:4 row_mask:0xf bank_mask:0xf bound_ctrl:0
    s_nop 1
    v_add_f32_dpp v4, v4, v4 row_shr:8 row_mask:0xf bank_mask:0xf bound_ctrl:0
    s_nop 1
    v_add_f32_dpp v4, v4, v4 row_bcast:15 row_mask:0xa bank_mask:0xf
    s_nop 1
    v_add_f32_dpp v4, v4, v4 row_bcast:31 row_mask:0xc bank_mask:0xf
    v_mul_f32 v4, 0x3a800000, v4
    s_nop 0
    v_readlane_b32 s68, v4, 63
    s_nop 1
    v_cvt_pk_bf16_f32 v150, s68, s68
    v_and_b32 v150, 0xffff0000, v150
    v_add_f32 v150, 0x3727c5ac, v150
    v_cvt_pk_bf16_f32 v150, v150, v150
    v_and_b32 v150, 0xffff0000, v150
    v_sqrt_f32 v150, v150
    s_waitcnt lgkmcnt(0)
    s_add_u32 s56, s56, 1
    s_mul_i32 s57, s88, 0x9e3779b2
    s_add_u32 s57, s57, s56
    s_mul_i32 s57, s57, 0x01010101
    s_add_u32 s88, s88, 1
    s_mov_b32 s72, 2000000
    s_mov_b32 s64, 4194304
    s_getreg_b32 s84, hwreg(HW_REG_XCC_ID, 0, 4)
    s_add_u32 s84, s84, 1
    s_lshl_b32 s84, s84, 27
    s_xor_b32 s82, s57, s84
    v_mov_b32 v8, v148
    v_mov_b32 v7, 0
    v_mov_b32 v11, 1
    v_cvt_pk_bf16_f32 v9, v150, v150
    v_and_b32 v9, 0xffff0000, v9
    v_rcp_f32 v10, v9
    s_nop 0
    ds_write_b128 v7, v[8:11] offset:14080
    buffer_load_dwordx4 v[100:103], v161, s[44:47], 0 offen
    buffer_load_dwordx4 v[108:111], v162, s[44:47], 0 offen offset:0
    buffer_load_dwordx4 v[108:111], v162, s[44:47], 0 offen offset:1024
    buffer_load_dwordx4 v[108:111], v162, s[44:47], 0 offen offset:2048
    buffer_load_dwordx4 v[108:111], v162, s[44:47], 0 offen offset:3072
    v_lshlrev_b32 v8, 3, v0
    v_and_b32 v160, 0x70, v2
    v_lshl_add_u32 v160, v1, 2, v160
    v_lshrrev_b32 v160, 1, v160
    s_mov_b32 s70, 0
    s_mov_b32 s71, 0
    s_mov_b32 s83, s82
    v_mov_b32 v16, s82
    v_lshrrev_b32 v17, 8, v16
    v_lshrrev_b32 v18, 16, v16
    v_lshrrev_b32 v19, 24, v16
    s_mov_b32 s73, 0xffffff00
    s_waitcnt vmcnt(0)
    s_barrier
    v_lshlrev_b32 v8, 4, v0
    ds_read_b128 v[68:71], v8 offset:0
    ds_read_b128 v[72:75], v8 offset:1024
    ds_read_b128 v[76:79], v8 offset:2048
    ds_read_b128 v[80:83], v8 offset:3072
    ds_read_b128 v[84:87], v8 offset:4096
    ds_read_b128 v[88:91], v8 offset:5120
    ds_read_b128 v[92:95], v8 offset:6144
    ds_read_b128 v[96:99], v8 offset:7168
    s_waitcnt lgkmcnt(6)
    v_pk_add_f32 v[68:69], v[68:69], v[72:73]
    v_pk_add_f32 v[70:71], v[70:71], v[74:75]
    s_waitcnt lgkmcnt(4)
    v_pk_add_f32 v[76:77], v[76:77], v[80:81]
    v_pk_add_f32 v[78:79], v[78:79], v[82:83]
    s_waitcnt lgkmcnt(2)
    v_pk_add_f32 v[84:85], v[84:85], v[88:89]
    v_pk_add_f32 v[86:87], v[86:87], v[90:91]
    s_waitcnt lgkmcnt(0)
    v_pk_add_f32 v[92:93], v[92:93], v[96:97]
    v_pk_add_f32 v[94:95], v[94:95], v[98:99]
    v_pk_add_f32 v[68:69], v[68:69], v[76:77]
    v_pk_add_f32 v[70:71], v[70:71], v[78:79]
    v_pk_add_f32 v[84:85], v[84:85], v[92:93]
    v_pk_add_f32 v[86:87], v[86:87], v[94:95]
    v_pk_add_f32 v[68:69], v[68:69], v[84:85]
    v_pk_add_f32 v[70:71], v[70:71], v[86:87]
    v_add_u32 v68, 0x80, v68
    v_add_u32 v69, 0x80, v69
    v_add_u32 v70, 0x80, v70
    v_add_u32 v71, 0x80, v71
    v_bfi_b32 v32, s73, v68, v16
    v_bfi_b32 v33, s73, v69, v17
    v_bfi_b32 v34, s73, v70, v18
    v_bfi_b32 v35, s73, v71, v19
    buffer_store_dwordx4 v[32:35], v161, s[44:47], 0 offen
    s_barrier
    s_barrier
    s_barrier
    s_barrier
    s_barrier
    s_barrier
    s_barrier
LS_poll:
    buffer_load_dwordx4 v[100:103], v162, s[44:47], s70 offen offset:0 sc1
    buffer_load_dwordx4 v[104:107], v162, s[44:47], s70 offen offset:1024 sc1
    buffer_load_dwordx4 v[108:111], v162, s[44:47], s70 offen offset:2048 sc1
    buffer_load_dwordx4 v[112:115], v162, s[44:47], s70 offen offset:3072 sc1
    s_waitcnt vmcnt(0)
    v_cmp_ne_u32 vcc, s83, v103
    v_cmp_ne_u32 s[74:75], s83, v107
    v_cmp_ne_u32 s[76:77], s83, v111
    v_cmp_ne_u32 s[78:79], s83, v115
    v_max3_f32 v4, v102, v106, v110
    v_max_f32 v4, v4, v114
    v_lshlrev_b32 v116, 16, v100
    v_and_b32 v117, 0xffff0000, v100
    v_lshlrev_b32 v120, 16, v104
    v_and_b32 v121, 0xffff0000, v104
    s_or_b64 s[74:75], s[74:75], vcc
    s_or_b64 s[76:77], s[76:77], s[78:79]
    s_or_b64 s[74:75], s[74:75], s[76:77]
    s_cbranch_scc0 LS_ok
    s_add_u32 s71, s71, 1
    s_cmp_lt_u32 s71, 32
    s_cbranch_scc1 LS_poll
    s_cmp_lg_u32 s71, 32
    s_cbranch_scc1 LS_poll_sw
    s_lshl_b32 s66, s58, 17
    s_lshl_b32 s67, s59, 7
    s_add_u32 s66, s66, s67
    s_add_u32 s66, s66, 262144
    v_and_b32 v4, 7, v0
    v_lshlrev_b32 v4, 14, v4
    v_lshrrev_b32 v5, 3, v0
    v_lshlrev_b32 v5, 4, v5
    v_add3_u32 v4, v4, v5, s66
    v_lshlrev_b32 v6, 4, v0
    ds_read_b128 v[36:39], v6 offset:0
    s_waitcnt lgkmcnt(0)
    v_mov_b32 v39, s57
    buffer_store_dwordx4 v[36:39], v4, s[44:47], s64 offen sc1
    v_add_u32 v4, 4096, v4
    ds_read_b128 v[40:43], v6 offset:1024
    s_waitcnt lgkmcnt(0)
    v_mov_b32 v43, s57
    buffer_store_dwordx4 v[40:43], v4, s[44:47], s64 offen sc1
    v_add_u32 v4, 4096, v4
    ds_read_b128 v[44:47], v6 offset:2048
    s_waitcnt lgkmcnt(0)
    v_mov_b32 v47, s57
    buffer_store_dwordx4 v[44:47], v4, s[44:47], s64 offen sc1
    v_add_u32 v4, 4096, v4
    ds_read_b128 v[48:51], v6 offset:3072
    s_waitcnt lgkmcnt(0)
    v_mov_b32 v51, s57
    buffer_store_dwordx4 v[48:51], v4, s[44:47], s64 offen sc1
    v_add_u32 v4, 4096, v4
LS_poll_sw:
    s_xor_b32 s70, s70, s64
    s_xor_b32 s83, s83, s84
    s_sub_u32 s72, s72, 1
    s_cbranch_scc0 LS_poll
    s_mov_b32 s72, 0
LS_ok:
    v_max_f32_dpp v4, v4, v4 row_ror:8 row_mask:0xf bank_mask:0xf
    v_lshlrev_b32 v118, 16, v101
    v_lshlrev_b32 v122, 16, v105
    v_mov_b32 v5, v4
    v_and_b32 v119, 0xffff0000, v101
    v_and_b32 v123, 0xffff0000, v105
    v_permlane16_swap_b32 v4, v5
    v_max_f32 v4, v4, v5
    v_mov_b32 v5, v4
    v_lshlrev_b32 v124, 16, v108
    v_lshlrev_b32 v128, 16, v112
    v_permlane32_swap_b32 v4, v5
    v_max_f32 v4, v4, v5
    v_sub_f32 v102, v102, v4
    v_sub_f32 v106, v106, v4
    v_sub_f32 v110, v110, v4
    v_sub_f32 v114, v114, v4
    v_exp_f32 v102, v102
    v_exp_f32 v106, v106
    v_exp_f32 v110, v110
    v_exp_f32 v114, v114
    v_and_b32 v125, 0xffff0000, v108
    v_lshlrev_b32 v126, 16, v109
    v_and_b32 v127, 0xffff0000, v109
    v_and_b32 v129, 0xffff0000, v112
    v_lshlrev_b32 v130, 16, v113
    v_and_b32 v131, 0xffff0000, v113
    v_pk_mul_f32 v[28:29], v[116:117], v[102:103] op_sel_hi:[1,0]
    v_pk_mul_f32 v[30:31], v[118:119], v[102:103] op_sel_hi:[1,0]
    v_add_f32 v4, v102, v106
    v_add_f32 v5, v110, v114
    v_pk_fma_f32 v[28:29], v[120:121], v[106:107], v[28:29] op_sel_hi:[1,0,1]
    v_pk_fma_f32 v[30:31], v[122:123], v[106:107], v[30:31] op_sel_hi:[1,0,1]
    v_add_f32 v4, v4, v5
    v_pk_fma_f32 v[28:29], v[124:125], v[110:111], v[28:29] op_sel_hi:[1,0,1]
    v_pk_fma_f32 v[30:31], v[126:127], v[110:111], v[30:31] op_sel_hi:[1,0,1]
    v_add_f32_dpp v4, v4, v4 row_ror:8 row_mask:0xf bank_mask:0xf
    v_mov_b32 v5, v4
    v_pk_fma_f32 v[28:29], v[128:129], v[114:115], v[28:29] op_sel_hi:[1,0,1]
    v_pk_fma_f32 v[30:31], v[130:131], v[114:115], v[30:31] op_sel_hi:[1,0,1]
    v_permlane32_swap_b32 v4, v5
    v_add_f32 v4, v4, v5
    v_mov_b32 v5, v4
    v_permlane32_swap_b32 v28, v30
    v_permlane32_swap_b32 v29, v31
    v_permlane16_swap_b32 v4, v5
    v_pk_add_f32 v[28:29], v[28:29], v[30:31]
    v_add_f32 v4, v4, v5
    v_rcp_f32 v4, v4
    v_permlane16_swap_b32 v28, v29
    v_add_f32 v28, v28, v29
    s_nop 1
    v_add_f32_dpp v28, v28, v28 row_ror:8 row_mask:0xf bank_mask:0xf
    v_mul_f32 v28, v28, v4
    v_cvt_pk_bf16_f32 v28, v28, v28
    ds_write_b16 v160, v28 offset:13376
    s_waitcnt lgkmcnt(0)
    s_barrier
    s_endpgm
L_roleB:
    s_mov_b64 s[48:49], s[4:5]
    s_mov_b32 s50, 2048
    s_mov_b32 s51, 0x20000
    s_lshl_b32 s67, s66, 1
    v_lshlrev_b32 v5, 2, v2
    v_lshl_add_u32 v4, v4, 1, v5
    v_add_u32 v156, s67, v4
    buffer_load_ushort v108, v156, s[48:51], 0 offen
    s_mul_i32 s60, s58, 28
    s_add_u32 s60, s60, s59
    s_mov_b64 s[32:33], s[20:21]
    s_mov_b32 s34, 7340032
    s_mov_b32 s35, 0x20000
    s_mov_b64 s[44:45], s[26:27]
    s_mov_b32 s46, 268435456
    s_mov_b32 s47, 0x20000
    s_mov_b64 s[52:53], s[22:23]
    s_mov_b32 s54, 2048
    s_mov_b32 s55, 0x20000
    s_lshl_b32 s61, s58, 4
    s_add_u32 s61, s61, s59
    s_cmp_lt_u32 s59, 16
    s_cselect_b32 s61, s61, -1
    s_lshl_b32 s68, s61, 5
    v_lshrrev_b32 v7, 3, v2
    v_add_u32 v7, s68, v7
    buffer_load_ushort v158, v7, s[48:51], 0 offen
    v_and_b32 v4, 1, v0
    v_lshlrev_b32 v4, 4, v4
    v_mov_b32 v5, 0xffff
    v_lshlrev_b32 v5, v4, v5
    v_bfe_u32 v6, v0, 1, 2
    v_cmp_eq_u32 s[74:75], 0, v6
    v_cmp_eq_u32 s[76:77], 1, v6
    v_cmp_eq_u32 s[78:79], 2, v6
    v_cmp_eq_u32 vcc, 3, v6
    v_cndmask_b32 v12, 0, v5, s[74:75]
    v_cndmask_b32 v13, 0, v5, s[76:77]
    v_cndmask_b32 v14, 0, v5, s[78:79]
    v_cndmask_b32 v15, 0, v5, vcc
    v_and_b32 v4, 112, v2
    v_lshl_add_u32 v160, v1, 2, v4
    s_lshl_b32 s68, s3, 9
    v_lshlrev_b32 v4, 1, v2
    v_lshl_add_u32 v4, v1, 4, v4
    v_add_u32 v159, s68, v4
    s_lshl_b32 s66, s60, 5
    s_lshl_b32 s68, s66, 11
    s_lshl_b32 s69, s3, 8
    s_add_u32 s68, s68, s69
    v_lshlrev_b32 v4, 11, v1
    v_add3_u32 v155, v4, v2, s68
    s_mov_b32 s63, 0
    s_lshl_b32 s68, s3, 12
    s_lshr_b32 s69, s61, 1
    s_lshl_b32 s69, s69, 15
    s_add_u32 s68, s68, s69
    s_and_b32 s69, s61, 1
    s_lshl_b32 s69, s69, 6
    s_add_u32 s68, s68, s69
    s_add_u32 s68, s68, 1048576
    v_lshrrev_b32 v4, 2, v0
    v_lshlrev_b32 v4, 7, v4
    v_and_b32 v5, 3, v0
    v_lshlrev_b32 v5, 4, v5
    v_add3_u32 v163, v4, v5, s68
    s_add_u32 s60, s60, 128
    v_bfe_u32 v4, v0, 2, 2
    v_lshlrev_b32 v4, 15, v4
    v_and_b32 v5, 3, v0
    v_lshlrev_b32 v5, 5, v5
    v_and_b32 v6, 16, v0
    v_add3_u32 v4, v4, v5, v6
    s_lshl_b32 s68, s3, 17
    s_lshl_b32 s69, s60, 7
    s_add_u32 s68, s68, s69
    s_add_u32 s68, s68, 1048576
    v_add_u32 v157, s68, v4
    s_waitcnt lgkmcnt(0)
    s_add_u32 s56, s56, 1
    s_mul_i32 s57, s88, 0x9e3779b2
    s_add_u32 s57, s57, s56
    s_mul_i32 s57, s57, 0x01010101
    s_add_u32 s88, s88, 1
    v_mov_b32 v16, s57
    v_lshrrev_b32 v17, 8, v16
    v_lshrrev_b32 v18, 16, v16
    v_lshrrev_b32 v19, 24, v16
    s_mov_b32 s73, 0xffffff00
    s_mov_b32 s72, 2000000
    s_mov_b32 s64, 4194304
    s_getreg_b32 s84, hwreg(HW_REG_XCC_ID, 0, 4)
    s_add_u32 s84, s84, 1
    s_lshl_b32 s84, s84, 27
    s_xor_b32 s82, s57, s84
    s_barrier
    s_waitcnt vmcnt(4)
    buffer_load_dwordx4 v[48:51], v154, s[28:31], s62 offen nt
    s_add_u32 s62, s62, s65
    s_waitcnt vmcnt(4)
    buffer_load_dwordx4 v[52:55], v154, s[28:31], s62 offen nt
    s_add_u32 s62, s62, s65
    s_waitcnt vmcnt(4)
    buffer_load_dwordx4 v[56:59], v154, s[28:31], s62 offen nt
    s_add_u32 s62, s62, s65
    s_waitcnt vmcnt(4)
    v_mov_b32 v7, 0
    v_lshlrev_b32 v116, 16, v108
LB_ln:
    ds_read_b128 v[8:11], v7 offset:14080
    s_waitcnt lgkmcnt(0)
    v_cmp_eq_u32 vcc, 0, v11
    s_cbranch_vccnz LB_ln
    v_sub_f32 v116, v116, v8
    v_cvt_pk_bf16_f32 v116, v116, v116
    v_and_b32 v116, 0xffff0000, v116
    v_mul_f32 v4, v116, v10
    v_fma_f32 v5, -v4, v9, v116
    v_fma_f32 v4, v5, v10, v4
    v_cvt_pk_bf16_f32 v3, v4, v4
    s_nop 1
    v_and_b32_dpp v20, v3, v12 row_newbcast:0 row_mask:0xf bank_mask:0xf
    v_and_b32_dpp v21, v3, v13 row_newbcast:0 row_mask:0xf bank_mask:0xf
    v_and_b32_dpp v22, v3, v14 row_newbcast:0 row_mask:0xf bank_mask:0xf
    v_and_b32_dpp v23, v3, v15 row_newbcast:0 row_mask:0xf bank_mask:0xf
    v_and_b32_dpp v24, v3, v12 row_newbcast:1 row_mask:0xf bank_mask:0xf
    v_and_b32_dpp v25, v3, v13 row_newbcast:1 row_mask:0xf bank_mask:0xf
    v_and_b32_dpp v26, v3, v14 row_newbcast:1 row_mask:0xf bank_mask:0xf
    v_and_b32_dpp v27, v3, v15 row_newbcast:1 row_mask:0xf bank_mask:0xf
    s_waitcnt vmcnt(7)
    v_mfma_f32_16x16x32_bf16 v[28:31], v[20:23], v[36:39], 0
    v_and_b32_dpp v20, v3, v12 row_newbcast:2 row_mask:0xf bank_mask:0xf
    v_and_b32_dpp v21, v3, v13 row_newbcast:2 row_mask:0xf bank_mask:0xf
    v_and_b32_dpp v22, v3, v14 row_newbcast:2 row_mask:0xf bank_mask:0xf
    v_and_b32_dpp v23, v3, v15 row_newbcast:2 row_mask:0xf bank_mask:0xf
    s_waitcnt vmcnt(6)
    v_mfma_f32_16x16x32_bf16 v[28:31], v[24:27], v[40:43], v[28:31]
    v_and_b32_dpp v24, v3, v12 row_newbcast:3 row_mask:0xf bank_mask:0xf
    v_and_b32_dpp v25, v3, v13 row_newbcast:3 row_mask:0xf bank_mask:0xf
    v_and_b32_dpp v26, v3, v14 row_newbcast:3 row_mask:0xf bank_mask:0xf
    v_and_b32_dpp v27, v3, v15 row_newbcast:3 row_mask:0xf bank_mask:0xf
    s_waitcnt vmcnt(5)
    v_mfma_f32_16x16x32_bf16 v[28:31], v[20:23], v[44:47], v[28:31]
    v_and_b32_dpp v20, v3, v12 row_newbcast:4 row_mask:0xf bank_mask:0xf
    v_and_b32_dpp v21, v3, v13 row_newbcast:4 row_mask:0xf bank_mask:0xf
    v_and_b32_dpp v22, v3, v14 row_newbcast:4 row_mask:0xf bank_mask:0xf
    v_and_b32_dpp v23, v3, v15 row_newbcast:4 row_mask:0xf bank_mask:0xf
    s_waitcnt vmcnt(2)
    v_mfma_f32_16x16x32_bf16 v[28:31], v[24:27], v[48:51], v[28:31]
    buffer_load_dwordx4 v[60:63], v154, s[28:31], s62 offen nt
    s_add_u32 s62, s62, s65
    v_and_b32_dpp v24, v3, v12 row_newbcast:5 row_mask:0xf bank_mask:0xf
    v_and_b32_dpp v25, v3, v13 row_newbcast:5 row_mask:0xf bank_mask:0xf
    v_and_b32_dpp v26, v3, v14 row_newbcast:5 row_mask:0xf bank_mask:0xf
    v_and_b32_dpp v27, v3, v15 row_newbcast:5 row_mask:0xf bank_mask:0xf
    s_waitcnt vmcnt(2)
    v_mfma_f32_16x16x32_bf16 v[28:31], v[20:23], v[52:55], v[28:31]
    buffer_load_dwordx4 v[64:67], v154, s[28:31], s62 offen nt
    s_add_u32 s62, s62, s65
    v_and_b32_dpp v20, v3, v12 row_newbcast:6 row_mask:0xf bank_mask:0xf
    v_and_b32_dpp v21, v3, v13 row_newbcast:6 row_mask:0xf bank_mask:0xf
    v_and_b32_dpp v22, v3, v14 row_newbcast:6 row_mask:0xf bank_mask:0xf
    v_and_b32_dpp v23, v3, v15 row_newbcast:6 row_mask:0xf bank_mask:0xf
    s_waitcnt vmcnt(2)
    v_mfma_f32_16x16x32_bf16 v[28:31], v[24:27], v[56:59], v[28:31]
    buffer_load_dwordx4 v[36:39], v154, s[28:31], s62 offen nt
    s_add_u32 s62, s62, s65
    v_and_b32_dpp v24, v3, v12 row_newbcast:7 row_mask:0xf bank_mask:0xf
    v_and_b32_dpp v25, v3, v13 row_newbcast:7 row_mask:0xf bank_mask:0xf
    v_and_b32_dpp v26, v3, v14 row_newbcast:7 row_mask:0xf bank_mask:0xf
    v_and_b32_dpp v27, v3, v15 row_newbcast:7 row_mask:0xf bank_mask:0xf
    s_waitcnt vmcnt(2)
    v_mfma_f32_16x16x32_bf16 v[28:31], v[20:23], v[60:63], v[28:31]
    buffer_load_dwordx4 v[40:43], v154, s[28:31], s62 offen nt
    s_add_u32 s62, s62, s65
    v_and_b32_dpp v20, v3, v12 row_newbcast:8 row_mask:0xf bank_mask:0xf
    v_and_b32_dpp v21, v3, v13 row_newbcast:8 row_mask:0xf bank_mask:0xf
    v_and_b32_dpp v22, v3, v14 row_newbcast:8 row_mask:0xf bank_mask:0xf
    v_and_b32_dpp v23, v3, v15 row_newbcast:8 row_mask:0xf bank_mask:0xf
    s_waitcnt vmcnt(2)
    v_mfma_f32_16x16x32_bf16 v[28:31], v[24:27], v[64:67], v[28:31]
    buffer_load_dwordx4 v[44:47], v154, s[28:31], s62 offen nt
    s_add_u32 s62, s62, s65
    v_and_b32_dpp v24, v3, v12 row_newbcast:9 row_mask:0xf bank_mask:0xf
    v_and_b32_dpp v25, v3, v13 row_newbcast:9 row_mask:0xf bank_mask:0xf
    v_and_b32_dpp v26, v3, v14 row_newbcast:9 row_mask:0xf bank_mask:0xf
    v_and_b32_dpp v27, v3, v15 row_newbcast:9 row_mask:0xf bank_mask:0xf
    s_waitcnt vmcnt(2)
    v_mfma_f32_16x16x32_bf16 v[28:31], v[20:23], v[36:39], v[28:31]
    buffer_load_dwordx4 v[48:51], v154, s[28:31], s62 offen nt
    s_add_u32 s62, s62, s65
    v_and_b32_dpp v20, v3, v12 row_newbcast:10 row_mask:0xf bank_mask:0xf
    v_and_b32_dpp v21, v3, v13 row_newbcast:10 row_mask:0xf bank_mask:0xf
    v_and_b32_dpp v22, v3, v14 row_newbcast:10 row_mask:0xf bank_mask:0xf
    v_and_b32_dpp v23, v3, v15 row_newbcast:10 row_mask:0xf bank_mask:0xf
    s_waitcnt vmcnt(2)
    v_mfma_f32_16x16x32_bf16 v[28:31], v[24:27], v[40:43], v[28:31]
    buffer_load_dwordx4 v[52:55], v154, s[28:31], s62 offen nt
    s_add_u32 s62, s62, s65
    v_and_b32_dpp v24, v3, v12 row_newbcast:11 row_mask:0xf bank_mask:0xf
    v_and_b32_dpp v25, v3, v13 row_newbcast:11 row_mask:0xf bank_mask:0xf
    v_and_b32_dpp v26, v3, v14 row_newbcast:11 row_mask:0xf bank_mask:0xf
    v_and_b32_dpp v27, v3, v15 row_newbcast:11 row_mask:0xf bank_mask:0xf
    s_waitcnt vmcnt(2)
    v_mfma_f32_16x16x32_bf16 v[28:31], v[20:23], v[44:47], v[28:31]
    buffer_load_dwordx4 v[56:59], v154, s[28:31], s62 offen nt
    s_add_u32 s62, s62, s65
    v_and_b32_dpp v20, v3, v12 row_newbcast:12 row_mask:0xf bank_mask:0xf
    v_and_b32_dpp v21, v3, v13 row_newbcast:12 row_mask:0xf bank_mask:0xf
    v_and_b32_dpp v22, v3, v14 row_newbcast:12 row_mask:0xf bank_mask:0xf
    v_and_b32_dpp v23, v3, v15 row_newbcast:12 row_mask:0xf bank_mask:0xf
    s_waitcnt vmcnt(2)
    v_mfma_f32_16x16x32_bf16 v[28:31], v[24:27], v[48:51], v[28:31]
    buffer_load_dwordx4 v[60:63], v154, s[28:31], s62 offen nt
    s_add_u32 s62, s62, s65
    v_and_b32_dpp v24, v3, v12 row_newbcast:13 row_mask:0xf bank_mask:0xf
    v_and_b32_dpp v25, v3, v13 row_newbcast:13 row_mask:0xf bank_mask:0xf
    v_and_b32_dpp v26, v3, v14 row_newbcast:13 row_mask:0xf bank_mask:0xf
    v_and_b32_dpp v27, v3, v15 row_newbcast:13 row_mask:0xf bank_mask:0xf
    s_waitcnt vmcnt(2)
    v_mfma_f32_16x16x32_bf16 v[28:31], v[20:23], v[52:55], v[28:31]
    buffer_load_dwordx4 v[64:67], v154, s[28:31], s62 offen nt
    v_and_b32_dpp v20, v3, v12 row_newbcast:14 row_mask:0xf bank_mask:0xf
    v_and_b32_dpp v21, v3, v13 row_newbcast:14 row_mask:0xf bank_mask:0xf
    v_and_b32_dpp v22, v3, v14 row_newbcast:14 row_mask:0xf bank_mask:0xf
    v_and_b32_dpp v23, v3, v15 row_newbcast:14 row_mask:0xf bank_mask:0xf
    s_waitcnt vmcnt(2)
    v_mfma_f32_16x16x32_bf16 v[28:31], v[24:27], v[56:59], v[28:31]
    buffer_load_dwordx4 v[68:71], v155, s[32:35], s63 offen nt
    s_add_u32 s63, s63, 8192
    v_and_b32_dpp v24, v3, v12 row_newbcast:15 row_mask:0xf bank_mask:0xf
    v_and_b32_dpp v25, v3, v13 row_newbcast:15 row_mask:0xf bank_mask:0xf
    v_and_b32_dpp v26, v3, v14 row_newbcast:15 row_mask:0xf bank_mask:0xf
    v_and_b32_dpp v27, v3, v15 row_newbcast:15 row_mask:0xf bank_mask:0xf
    s_waitcnt vmcnt(2)
    v_mfma_f32_16x16x32_bf16 v[28:31], v[20:23], v[60:63], v[28:31]
    s_waitcnt vmcnt(1)
    v_mfma_f32_16x16x32_bf16 v[28:31], v[24:27], v[64:67], v[28:31]
    s_mov_b32 exec_hi, 0
    s_nop 6
    ds_write_b128 v159, v[28:31] offset:0
    s_mov_b32 exec_hi, -1
    s_waitcnt lgkmcnt(0)
    s_barrier
    s_barrier
    buffer_load_dwordx4 v[72:75], v155, s[32:35], s63 offen nt
    s_add_u32 s63, s63, 8192
    buffer_load_dwordx4 v[76:79], v155, s[32:35], s63 offen nt
    s_add_u32 s63, s63, 8192
    buffer_load_dwordx4 v[80:83], v155, s[32:35], s63 offen nt
    s_add_u32 s63, s63, 8192
    buffer_load_dwordx4 v[84:87], v155, s[32:35], s63 offen nt
    s_add_u32 s63, s63, 8192
    s_waitcnt vmcnt(3)
    buffer_load_dwordx4 v[88:91], v155, s[32:35], s63 offen nt
    s_add_u32 s63, s63, 8192
    s_waitcnt vmcnt(3)
    buffer_load_dwordx4 v[92:95], v155, s[32:35], s63 offen nt
    s_add_u32 s63, s63, 8192
    s_waitcnt vmcnt(3)
    buffer_load_dwordx4 v[96:99], v155, s[32:35], s63 offen nt
    s_add_u32 s63, s63, 8192
    v_bfe_u32 v4, v0, 2, 1
    v_add_u32 v5, -1, v4
    v_sub_u32 v4, 0, v4
    v_and_b32 v12, 0xffff, v5
    v_and_b32 v13, 0xffff, v4
    v_and_b32 v14, 0xffff0000, v5
    v_and_b32 v15, 0xffff0000, v4
    v_and_b32 v4, 3, v0
    v_xor_b32 v5, 1, v4
    v_lshl_or_b32 v6, v5, 2, v4
    v_lshl_or_b32 v7, v4, 2, v5
    v_lshl_or_b32 v6, v7, 8, v6
    v_lshl_or_b32 v150, v6, 4, v6
    v_lshlrev_b32 v4, 4, v4
    v_lshl_add_u32 v160, v1, 2, v4
    v_mov_b32 v28, 0
    v_mov_b32 v29, 0
    v_mov_b32 v30, 0
    v_mov_b32 v31, 0
    s_barrier
    ds_read_b32 v3, v160 offset:13376
    s_waitcnt lgkmcnt(0)
    v_and_b32_dpp v20, v3, v12 row_newbcast:0 row_mask:0xf bank_mask:0xf
    v_and_b32_dpp v21, v3, v13 row_newbcast:0 row_mask:0xf bank_mask:0xf
    v_and_b32_dpp v22, v3, v14 row_newbcast:0 row_mask:0xf bank_mask:0xf
    v_and_b32_dpp v23, v3, v15 row_newbcast:0 row_mask:0xf bank_mask:0xf
    v_and_b32_dpp v24, v3, v12 row_newbcast:1 row_mask:0xf bank_mask:0xf
    v_and_b32_dpp v25, v3, v13 row_newbcast:1 row_mask:0xf bank_mask:0xf
    v_and_b32_dpp v26, v3, v14 row_newbcast:1 row_mask:0xf bank_mask:0xf
    v_and_b32_dpp v27, v3, v15 row_newbcast:1 row_mask:0xf bank_mask:0xf
    s_waitcnt vmcnt(6)
    v_smfmac_f32_16x16x64_bf16 v[28:31], v[20:23], v[68:75], v150
    v_and_b32_dpp v20, v3, v12 row_newbcast:2 row_mask:0xf bank_mask:0xf
    v_and_b32_dpp v21, v3, v13 row_newbcast:2 row_mask:0xf bank_mask:0xf
    v_and_b32_dpp v22, v3, v14 row_newbcast:2 row_mask:0xf bank_mask:0xf
    v_and_b32_dpp v23, v3, v15 row_newbcast:2 row_mask:0xf bank_mask:0xf
    s_waitcnt vmcnt(4)
    v_smfmac_f32_16x16x64_bf16 v[28:31], v[24:27], v[76:83], v150
    v_and_b32_dpp v24, v3, v12 row_newbcast:3 row_mask:0xf bank_mask:0xf
    v_and_b32_dpp v25, v3, v13 row_newbcast:3 row_mask:0xf bank_mask:0xf
    v_and_b32_dpp v26, v3, v14 row_newbcast:3 row_mask:0xf bank_mask:0xf
    v_and_b32_dpp v27, v3, v15 row_newbcast:3 row_mask:0xf bank_mask:0xf
    s_waitcnt vmcnt(2)
    v_smfmac_f32_16x16x64_bf16 v[28:31], v[20:23], v[84:91], v150
    s_waitcnt vmcnt(0)
    v_smfmac_f32_16x16x64_bf16 v[28:31], v[24:27], v[92:99], v150
    s_mov_b32 exec_hi, 0
    s_nop 6
    v_bfi_b32 v4, s73, v28, v16
    v_bfi_b32 v5, s73, v29, v17
    v_bfi_b32 v6, s73, v30, v18
    v_bfi_b32 v7, s73, v31, v19
    buffer_store_dwordx4 v[4:7], v157, s[44:47], 0 offen sc1
    s_mov_b32 exec_hi, -1
    s_cmp_eq_u32 s61, -1
    s_cbranch_scc1 LB_done
    s_cmp_lt_u32 s3, 7
    s_cselect_b32 s67, 2048, 0
    s_mov_b32 s68, 0x0c0c0400
    s_mov_b32 s69, 0x04000c0c
    s_mov_b32 exec_lo, 0x0
    s_mov_b32 exec_hi, 0xf0000000
LB_fh:
    buffer_load_dwordx4 v[100:103], v163, s[44:47], s67 offen sc1
    s_waitcnt vmcnt(0)
    v_perm_b32 v4, v101, v100, s68
    v_perm_b32 v5, v103, v102, s69
    v_or_b32 v4, v4, v5
    v_cmp_ne_u32 vcc, s57, v4
    s_cbranch_vccz LB_fh2
    s_sub_u32 s72, s72, 1
    s_cbranch_scc0 LB_fh
    s_mov_b32 s72, 0
LB_fh2:
    s_mov_b64 exec, -1
    buffer_load_dwordx4 v[36:39], v163, s[44:47], 0 offen sc1
    buffer_load_dwordx4 v[40:43], v163, s[44:47], s67 offen sc1
    s_cmp_eq_u32 s67, 0
    s_cselect_b32 s66, 0, s73
    v_and_b32 v8, 3, v0
    v_lshlrev_b32 v8, 7, v8
    v_lshl_add_u32 v8, v1, 5, v8
    s_lshl_b32 s78, s3, 2
    v_add_u32 v8, s78, v8
    s_branch LB_fsel
LB_fagain:
    s_mov_b64 exec, vcc
    s_cbranch_execz LB_fs1
    buffer_load_dwordx4 v[36:39], v163, s[44:47], 0 offen sc1
LB_fs1:
    s_mov_b64 exec, s[74:75]
    s_cbranch_execz LB_fs2
    buffer_load_dwordx4 v[40:43], v163, s[44:47], s67 offen sc1
LB_fs2:
    s_mov_b64 exec, -1
    s_sub_u32 s72, s72, 1
    s_cbranch_scc1 LB_fok
LB_fsel:
    s_waitcnt vmcnt(0)
    v_perm_b32 v4, v37, v36, s68
    v_perm_b32 v5, v39, v38, s69
    v_or_b32 v4, v4, v5
    v_perm_b32 v6, v41, v40, s68
    v_perm_b32 v7, v43, v42, s69
    v_or_b32 v6, v6, v7
    v_cmp_ne_u32 vcc, s57, v4
    v_cmp_ne_u32 s[74:75], s57, v6
    v_and_b32 v100, s73, v36
    v_and_b32 v101, s73, v37
    v_and_b32 v102, s73, v38
    v_and_b32 v103, s73, v39
    v_and_b32 v104, s66, v40
    v_and_b32 v105, s66, v41
    v_and_b32 v106, s66, v42
    v_and_b32 v107, s66, v43
    s_or_b64 s[76:77], s[74:75], vcc
    s_cbranch_scc1 LB_fagain
LB_fok:
    v_pk_add_f32 v[100:101], v[100:101], v[104:105]
    v_pk_add_f32 v[102:103], v[102:103], v[106:107]
    s_nop 1
    v_permlane32_swap_b32 v100, v102
    v_permlane32_swap_b32 v101, v103
    v_pk_add_f32 v[100:101], v[100:101], v[102:103]
    s_nop 1
    v_permlane16_swap_b32 v100, v101
    v_add_f32 v100, v100, v101
    s_nop 1
    v_add_f32_dpp v100, v100, v100 row_ror:4 row_mask:0xf bank_mask:0xf
    s_nop 1
    v_add_f32_dpp v100, v100, v100 row_ror:8 row_mask:0xf bank_mask:0xf
    s_mov_b32 exec_lo, 0x000f000f
    s_mov_b32 exec_hi, 0x000f000f
    ds_write_b32 v8, v100 offset:13568
    s_mov_b64 exec, -1
    s_waitcnt lgkmcnt(0)
    s_barrier
    s_cmp_lg_u32 s3, 0
    s_cbranch_scc1 LB_done
    v_lshlrev_b32 v5, 1, v2
    ds_read_b128 v[100:103], v5 offset:13568
    ds_read_b128 v[104:107], v5 offset:13584
    s_lshl_b32 s68, s61, 5
    v_lshrrev_b32 v4, 3, v2
    v_add_u32 v4, s68, v4
    v_lshlrev_b32 v158, 16, v158
    s_waitcnt lgkmcnt(0)
    v_pk_add_f32 v[100:101], v[100:101], v[102:103]
    v_pk_add_f32 v[104:105], v[104:105], v[106:107]
    v_add_f32 v100, v100, v101
    v_add_f32 v104, v104, v105
    v_cvt_pk_bf16_f32 v100, v100, v104
    v_lshlrev_b32 v101, 16, v100
    v_and_b32 v102, 0xffff0000, v100
    v_add_f32 v101, v158, v101
    v_cvt_pk_bf16_f32 v101, v101, v101
    v_and_b32 v101, 0xffff0000, v101
    v_add_f32 v101, v101, v102
    v_cvt_pk_bf16_f32 v101, v101, v101
    s_mov_b32 exec_lo, 0xffff
    s_mov_b32 exec_hi, 0
    buffer_store_short v101, v4, s[52:55], 0 offen
    s_cmp_lg_u32 s61, 0
    s_cbranch_scc1 LB_noep
    s_mov_b32 exec_lo, 1
    v_mov_b32 v6, 0
    v_mov_b32 v7, s56
    buffer_store_dword v7, v6, s[44:47], 0 offen
    v_mov_b32 v8, 2097024
    v_mov_b32 v9, s88
    buffer_store_dword v9, v8, s[44:47], 0 offen
LB_noep:
    s_mov_b64 exec, -1
LB_done:
    s_endpgm
L_roleSB:
    s_mul_i32 s60, s58, 28
    s_add_u32 s60, s60, s59
    s_lshl_b32 s68, s60, 10
    s_add_u32 s68, s68, 786432
    v_lshl_add_u32 v162, v0, 4, s68
    s_and_b32 s68, s60, 0xfc
    s_lshl_b32 s68, s68, 10
    s_and_b32 s69, s60, 3
    s_lshl_b32 s69, s69, 8
    s_add_u32 s68, s68, s69
    s_add_u32 s68, s68, 786432
    v_lshlrev_b32 v4, 10, v1
    v_add3_u32 v161, v4, v2, s68
    s_waitcnt vmcnt(0)
    v_lshlrev_b32 v116, 16, v100
    v_and_b32 v117, 0xffff0000, v100
    v_lshlrev_b32 v118, 16, v101
    v_and_b32 v119, 0xffff0000, v101
    v_lshlrev_b32 v120, 16, v102
    v_and_b32 v121, 0xffff0000, v102
    v_lshlrev_b32 v122, 16, v103
    v_and_b32 v123, 0xffff0000, v103
    v_lshlrev_b32 v124, 16, v104
    v_and_b32 v125, 0xffff0000, v104
    v_lshlrev_b32 v126, 16, v105
    v_and_b32 v127, 0xffff0000, v105
    v_lshlrev_b32 v128, 16, v106
    v_and_b32 v129, 0xffff0000, v106
    v_lshlrev_b32 v130, 16, v107
    v_and_b32 v131, 0xffff0000, v107
    v_pk_add_f32 v[4:5], v[116:117], v[118:119]
    v_pk_add_f32 v[6:7], v[120:121], v[122:123]
    v_pk_add_f32 v[8:9], v[124:125], v[126:127]
    v_pk_add_f32 v[10:11], v[128:129], v[130:131]
    v_pk_add_f32 v[4:5], v[4:5], v[6:7]
    v_pk_add_f32 v[8:9], v[8:9], v[10:11]
    v_pk_add_f32 v[4:5], v[4:5], v[8:9]
    v_add_f32 v4, v4, v5
    s_nop 1
    v_add_f32_dpp v4, v4, v4 row_shr:1 row_mask:0xf bank_mask:0xf bound_ctrl:0
    s_nop 1
    v_add_f32_dpp v4, v4, v4 row_shr:2 row_mask:0xf bank_mask:0xf bound_ctrl:0
    s_nop 1
    v_add_f32_dpp v4, v4, v4 row_shr:4 row_mask:0xf bank_mask:0xf bound_ctrl:0
    s_nop 1
    v_add_f32_dpp v4, v4, v4 row_shr:8 row_mask:0xf bank_mask:0xf bound_ctrl:0
    s_nop 1
    v_add_f32_dpp v4, v4, v4 row_bcast:15 row_mask:0xa bank_mask:0xf
    s_nop 1
    v_add_f32_dpp v4, v4, v4 row_bcast:31 row_mask:0xc bank_mask:0xf
    v_mul_f32 v4, 0x3a800000, v4
    s_nop 0
    v_readlane_b32 s68, v4, 63
    s_nop 1
    v_pk_add_f32 v[116:117], v[116:117], s[68:69] op_sel_hi:[1,0] neg_lo:[0,1] neg_hi:[0,1]
    v_pk_add_f32 v[118:119], v[118:119], s[68:69] op_sel_hi:[1,0] neg_lo:[0,1] neg_hi:[0,1]
    v_pk_add_f32 v[120:121], v[120:121], s[68:69] op_sel_hi:[1,0] neg_lo:[0,1] neg_hi:[0,1]
    v_pk_add_f32 v[122:123], v[122:123], s[68:69] op_sel_hi:[1,0] neg_lo:[0,1] neg_hi:[0,1]
    v_pk_add_f32 v[124:125], v[124:125], s[68:69] op_sel_hi:[1,0] neg_lo:[0,1] neg_hi:[0,1]
    v_pk_add_f32 v[126:127], v[126:127], s[68:69] op_sel_hi:[1,0] neg_lo:[0,1] neg_hi:[0,1]
    v_pk_add_f32 v[128:129], v[128:129], s[68:69] op_sel_hi:[1,0] neg_lo:[0,1] neg_hi:[0,1]
    v_pk_add_f32 v[130:131], v[130:131], s[68:69] op_sel_hi:[1,0] neg_lo:[0,1] neg_hi:[0,1]
    v_pk_mul_f32 v[4:5], v[116:117], v[116:117]
    v_pk_mul_f32 v[6:7], v[118:119], v[118:119]
    v_pk_fma_f32 v[4:5], v[120:121], v[120:121], v[4:5]
    v_pk_fma_f32 v[6:7], v[122:123], v[122:123], v[6:7]
    v_pk_fma_f32 v[4:5], v[124:125], v[124:125], v[4:5]
    v_pk_fma_f32 v[6:7], v[126:127], v[126:127], v[6:7]
    v_pk_fma_f32 v[4:5], v[128:129], v[128:129], v[4:5]
    v_pk_fma_f32 v[6:7], v[130:131], v[130:131], v[6:7]
    v_pk_add_f32 v[4:5], v[4:5], v[6:7]
    v_add_f32 v4, v4, v5
    v_cvt_pk_bf16_f32 v148, s68, s68
    v_and_b32 v148, 0xffff0000, v148
    v_add_f32_dpp v4, v4, v4 row_shr:1 row_mask:0xf bank_mask:0xf bound_ctrl:0
    s_nop 1
    v_add_f32_dpp v4, v4, v4 row_shr:2 row_mask:0xf bank_mask:0xf bound_ctrl:0
    s_nop 1
    v_add_f32_dpp v4, v4, v4 row_shr:4 row_mask:0xf bank_mask:0xf bound_ctrl:0
    s_nop 1
    v_add_f32_dpp v4, v4, v4 row_shr:8 row_mask:0xf bank_mask:0xf bound_ctrl:0
    s_nop 1
    v_add_f32_dpp v4, v4, v4 row_bcast:15 row_mask:0xa bank_mask:0xf
    s_nop 1
    v_add_f32_dpp v4, v4, v4 row_bcast:31 row_mask:0xc bank_mask:0xf
    v_mul_f32 v4, 0x3a800000, v4
    s_nop 0
    v_readlane_b32 s68, v4, 63
    s_nop 1
    v_cvt_pk_bf16_f32 v150, s68, s68
    v_and_b32 v150, 0xffff0000, v150
    v_add_f32 v150, 0x3727c5ac, v150
    v_cvt_pk_bf16_f32 v150, v150, v150
    v_and_b32 v150, 0xffff0000, v150
    v_sqrt_f32 v150, v150
    s_waitcnt lgkmcnt(0)
    s_add_u32 s56, s56, 1
    s_mul_i32 s57, s88, 0x9e3779b2
    s_add_u32 s57, s57, s56
    s_mul_i32 s57, s57, 0x01010101
    s_add_u32 s88, s88, 1
    s_mov_b32 s72, 2000000
    s_mov_b32 s64, 4194304
    s_getreg_b32 s84, hwreg(HW_REG_XCC_ID, 0, 4)
    s_add_u32 s84, s84, 1
    s_lshl_b32 s84, s84, 27
    s_xor_b32 s82, s57, s84
    v_mov_b32 v8, v148
    v_mov_b32 v7, 0
    v_mov_b32 v11, 1
    v_cvt_pk_bf16_f32 v9, v150, v150
    v_and_b32 v9, 0xffff0000, v9
    v_rcp_f32 v10, v9
    s_nop 0
    ds_write_b128 v7, v[8:11] offset:14080
    buffer_load_dwordx4 v[100:103], v162, s[44:47], 0 offen
    v_lshlrev_b32 v8, 3, v0
    s_mov_b32 s70, 0
    s_mov_b32 s71, 0
    s_mov_b32 s83, s82
    s_waitcnt vmcnt(0)
    s_barrier
    ds_read_b64 v[116:117], v8 offset:0
    ds_read_b64 v[118:119], v8 offset:512
    ds_read_b64 v[120:121], v8 offset:1024
    ds_read_b64 v[122:123], v8 offset:1536
    ds_read_b64 v[124:125], v8 offset:2048
    ds_read_b64 v[126:127], v8 offset:2560
    ds_read_b64 v[128:129], v8 offset:3072
    ds_read_b64 v[130:131], v8 offset:3584
    v_mov_b32 v34, s82
    v_mov_b32 v35, s82
    s_waitcnt lgkmcnt(4)
    v_pk_add_f32 v[116:117], v[116:117], v[118:119]
    v_pk_add_f32 v[120:121], v[120:121], v[122:123]
    s_waitcnt lgkmcnt(0)
    v_pk_add_f32 v[124:125], v[124:125], v[126:127]
    v_pk_add_f32 v[128:129], v[128:129], v[130:131]
    v_pk_add_f32 v[116:117], v[116:117], v[120:121]
    v_pk_add_f32 v[124:125], v[124:125], v[128:129]
    v_pk_add_f32 v[32:33], v[116:117], v[124:125]
    buffer_store_dwordx4 v[32:35], v161, s[44:47], 0 offen
    s_barrier
LB_xpoll:
    buffer_load_dwordx4 v[100:103], v162, s[44:47], s70 offen sc1
    s_waitcnt vmcnt(0)
    v_cmp_ne_u32 vcc, s83, v102
    s_cmp_eq_u64 vcc, 0
    s_cbranch_scc1 LB_xok
    s_add_u32 s71, s71, 1
    s_cmp_lt_u32 s71, 32
    s_cbranch_scc1 LB_xpoll
    s_cmp_lg_u32 s71, 32
    s_cbranch_scc1 LB_xpoll_sw
    v_mov_b32 v34, s57
    buffer_store_dwordx4 v[32:35], v161, s[44:47], s64 offen sc1
LB_xpoll_sw:
    s_xor_b32 s70, s70, s64
    s_xor_b32 s83, s83, s84
    s_sub_u32 s72, s72, 1
    s_cbranch_scc0 LB_xpoll
    s_mov_b32 s72, 0
LB_xok:
    v_permlane16_swap_b32 v100, v101
    v_add_f32 v100, v100, v101
    v_cvt_pk_bf16_f32 v100, v100, v100
    v_and_b32 v100, 0xffff0000, v100
    s_mov_b32 s68, 0x3d372713
    v_mul_f32 v116, v100, v100
    v_mov_b32 v101, v100
    v_fma_f32 v116, v116, s68, 1.0
    v_mul_f32 v116, v116, v100
    v_mul_f32 v116, 0xc0135761, v116
    v_permlane32_swap_b32 v101, v102
    v_exp_f32 v116, v116
    v_lshrrev_b32 v6, 2, v2
    v_add_f32 v116, 1.0, v116
    v_rcp_f32 v116, v116
    v_lshl_add_u32 v6, v1, 1, v6
    v_mul_f32 v116, v116, v100
    v_cvt_pk_bf16_f32 v116, v116, v116
    v_and_b32 v116, 0xffff0000, v116
    v_mul_f32 v116, v116, v102
    s_mov_b32 exec_hi, 0
    v_cvt_pk_bf16_f32 v116, v116, v116
    ds_write_b16 v6, v116 offset:13376
    s_mov_b32 exec_hi, -1
    s_waitcnt lgkmcnt(0)
    s_barrier
L_end:
    s_endpgm
.section .rodata,"a"
.p2align 6
.amdhsa_kernel parallel_sum__sliding_block_cached__geglu_ffn__decode_kernel
  .amdhsa_next_free_vgpr 168
  .amdhsa_next_free_sgpr 90
  .amdhsa_accum_offset 168
  .amdhsa_group_segment_fixed_size 0
  .amdhsa_kernarg_size 96
  .amdhsa_user_sgpr_count 2
  .amdhsa_user_sgpr_kernarg_segment_ptr 1
  .amdhsa_system_sgpr_workgroup_id_x 1
  .amdhsa_float_denorm_mode_32 3
.end_amdhsa_kernel
```
